```python
import torch

def _softmax(x, axis=-1):
    return torch.softmax(x, dim=axis)
def _gelu(x):
    return torch.nn.functional.gelu(x, approximate="tanh")
def _silu(x):
    return torch.nn.functional.silu(x)
def _sigmoid(x):
    return torch.sigmoid(x)
def _layernorm(x, axis=-1, eps=1e-5):
    m = x.mean(dim=axis, keepdim=True)
    v = x.var(dim=axis, keepdim=True, unbiased=False)
    return (x - m) / torch.sqrt(v + eps)
def _scatter_add(tgt, idx, src, axis=0):
    return tgt.clone().index_add_(axis, idx, src)
def _segment_sum(src, seg, n):
    out = torch.zeros((n,) + src.shape[1:], dtype=src.dtype)
    return out.index_add_(0, seg, src)
def _pad(x, pw):
    flat = tuple(v for pair in reversed(pw) for v in pair)
    return torch.nn.functional.pad(x, flat)

kernel_name = 'recurrent_scan__sliding_block_cached__dense_activation_squared_relu__decode'

def setup_inputs():

    _w = (lambda a: (lambda t: t.to(torch.bfloat16) if t.is_floating_point() else t)(torch.as_tensor(a)))
    def _A_setup():
        B, Sq, D = 2, 1, 512
        Hq, Hkv, Sk, Dh = 32, 32, 4096, 128
        assert Hq % Hkv == 0, (Hq, Hkv)
        return {
            "x": _w((lambda *s: torch.randn(*s, dtype=torch.bfloat16) * 0.05)(B, Sq, D)),
            "k_cache": _w((lambda *s: torch.randn(*s, dtype=torch.bfloat16) * 0.8)(B, Hkv, Sk, Dh)),
            "v_cache": _w((lambda *s: torch.randn(*s, dtype=torch.bfloat16) * 0.2)(B, Hkv, Sk, Dh)),
            "wq": _w((lambda *s: torch.randn(*s, dtype=torch.bfloat16) * 0.8)(D, Hq * Dh) * (D ** -0.5)),
            "wo": _w((lambda *s: torch.randn(*s, dtype=torch.bfloat16) * 0.2)(Hq * Dh, D) * ((Hq * Dh) ** -0.5)),
        }
    _A_in = _A_setup()

    def _B_setup():
        B, S, D, F = 2, 1, 512, 1376
        return {
            "x": _w((lambda *s: torch.randn(*s, dtype=torch.bfloat16) * 0.05)(B, S, D)),
            "w1": _w((lambda *s: torch.randn(*s, dtype=torch.bfloat16) * 0.1)(D, F)),
            "b1": _w((lambda *s: torch.randn(*s, dtype=torch.bfloat16) * 0.8)(F)),
            "w2": _w((lambda *s: torch.randn(*s, dtype=torch.bfloat16) * 0.1)(F, D)),
            "b2": _w((lambda *s: torch.randn(*s, dtype=torch.bfloat16) * 6.4)(D)),
        }
    _B_in = _B_setup()

    return {
        "A_x": _A_in["x"],
        "A_k_cache": _A_in["k_cache"],
        "A_v_cache": _A_in["v_cache"],
        "A_wq": _A_in["wq"],
        "A_wo": _A_in["wo"],
        "B_x": _B_in["x"],
        "B_w1": _B_in["w1"],
        "B_b1": _B_in["b1"],
        "B_w2": _B_in["w2"],
        "B_b2": _B_in["b2"],
    }

def reference(A_x, A_k_cache, A_v_cache, A_wq, A_wo, B_x, B_w1, B_b1, B_w2, B_b2):
    def _A_ref(x, k_cache, v_cache, wq, wo):
        B, Sq, D = x.shape
        Hq, Dh = 32, 128
        Hkv, Sk = k_cache.shape[1], k_cache.shape[2]
        W = min(4096, max(256, Sk // 4))
        rep = Hq // Hkv
        q = (lambda x, *d: x.permute(*d))((x @ wq).reshape(B, Sq, Hq, Dh), 0, 2, 1, 3)
        k = (lambda x, n, axis: torch.repeat_interleave(x, n, dim=axis))(k_cache[:, :, Sk - W:, :], rep, axis=1)
        v = (lambda x, n, axis: torch.repeat_interleave(x, n, dim=axis))(v_cache[:, :, Sk - W:, :], rep, axis=1)
        scores = torch.einsum("bhqd,bhkd->bhqk", q, k) * (Dh ** -0.5)
        p = _softmax(scores, axis=-1)
        o = torch.einsum("bhqk,bhkd->bhqd", p, v)
        return (lambda x, *d: x.permute(*d))(o, 0, 2, 1, 3).reshape(B, Sq, Hq * Dh) @ wo

    def _B_ref(x, w1, b1, w2, b2):
        h = torch.einsum("bsd,df->bsf", x, w1) + b1
        zero = torch.zeros_like(h)
        r = torch.where(h > zero, h, zero)
        h = r * r
        out = torch.einsum("bsf,fd->bsd", h, w2) + b2
        return out

    x = A_x
    xn = _layernorm(x, axis=-1)
    s = _A_ref(xn, A_k_cache, A_v_cache, A_wq, A_wo)
    g = _silu(_B_ref(xn, B_w1, B_b1, B_w2, B_b2))
    return x + s * g
```

```asm
; @launch grid=(256,1,1) block=(640,1,1) lds=81920
.amdgcn_target "amdgcn-amd-amdhsa--gfx950"
.text
.globl recurrent_scan__sliding_block_cached__dense_activation_squared_relu__decode_kernel
.p2align 8
.type recurrent_scan__sliding_block_cached__dense_activation_squared_relu__decode_kernel,@function
recurrent_scan__sliding_block_cached__dense_activation_squared_relu__decode_kernel:
    s_load_dwordx16 s[16:31], s[0:1], 0
    s_cmp_ge_u32 s2, 8
    s_cbranch_scc1 L_npf
    s_getpc_b64 s[100:101]
L_pc:
    v_lshlrev_b32 v8, 7, v0
    v_min_u32 v8, L_end-L_pc, v8
    global_load_dword v15, v8, s[100:101]
L_npf:
    s_load_dwordx8 s[32:39], s[0:1], 64
    s_load_dwordx2 s[40:41], s[0:1], 96
    v_lshrrev_b32 v9, 6, v0
    s_cmpk_ge_u32 s2, 256
    s_cbranch_scc1 L_end
    v_readfirstlane_b32 s3, v9
    v_and_b32 v2, 15, v0
    v_bfe_u32 v3, v0, 4, 2
    s_lshr_b32 s7, s2, 6
    s_lshl_b32 s4, s7, 3
    s_and_b32 s6, s2, 7
    s_add_u32 s4, s4, s6
    s_bfe_u32 s5, s2, 0x30003
    v_lshlrev_b32 v14, 4, v2
    s_cmp_ge_u32 s3, 2
    s_cbranch_scc1 L_stream
    s_setprio 3
    s_lshl_b32 s43, s6, 2
    s_add_u32 s43, s43, s7
    v_and_b32 v1, 63, v0
    v_and_b32 v13, 8, v0
    v_lshlrev_b32 v13, 7, v13
    v_lshlrev_b32 v9, 2, v1
    v_mov_b32 v10, 0
    ds_write_b32 v9, v10 offset:512
    s_movk_i32 s13, 2752
    s_movk_i32 s7, 96
    s_cmp_eq_u32 s3, 0
    s_cmovk_i32 s13, 8192
    s_cmovk_i32 s7, 256
    s_cselect_b32 s15, s4, s43
    s_lshl_b32 s54, s13, 9
    s_mul_i32 s7, s7, s15
    s_mul_i32 s15, s43, 6
    s_sub_i32 s15, 172, s15
    s_min_i32 s15, s15, 6
    s_cmp_eq_u32 s3, 0
    s_cselect_b32 s15, 16, s15
    s_mov_b32 s55, 0x20000
    v_and_b32 v9, 7, v0
    v_lshl_add_u32 v16, v9, 5, v13
    v_lshl_add_u32 v16, v3, 8, v16
    s_lshl_b32 s6, s5, 6
    v_lshl_add_u32 v10, v3, 4, s6
    v_lshl_add_u32 v17, v10, 1, v13
    v_mul_u32_u24 v18, s13, v10
    v_add3_u32 v18, v18, v14, s7
    v_cmp_gt_i32 vcc, s15, v2
    v_bfrev_b32 v11, 1
    s_mov_b32 s14, 0
    s_cmp_eq_u32 s3, 0
    v_cndmask_b32 v18, v11, v18, vcc
    s_waitcnt lgkmcnt(0)
    s_cselect_b32 s52, s22, s28
    s_cselect_b32 s53, s23, s29
    s_load_dword s8, s[40:41], 0
    s_cbranch_scc1 L_q0
    s_setprio 0
    s_barrier
L_q0:
    global_load_dwordx4 v[24:27], v16, s[16:17]
    global_load_dwordx4 v[28:31], v16, s[16:17] offset:16
    global_load_dwordx4 v[40:43], v17, s[16:17]
    global_load_dwordx4 v[44:47], v17, s[16:17] offset:16
    buffer_load_dwordx4 v[48:51], v18, s[52:55], s14 offen nt
    s_add_u32 s14, s14, s13
    buffer_load_dwordx4 v[52:55], v18, s[52:55], s14 offen nt
    s_add_u32 s14, s14, s13
    buffer_load_dwordx4 v[56:59], v18, s[52:55], s14 offen nt
    s_add_u32 s14, s14, s13
    buffer_load_dwordx4 v[60:63], v18, s[52:55], s14 offen nt
    s_add_u32 s14, s14, s13
    buffer_load_dwordx4 v[64:67], v18, s[52:55], s14 offen nt
    s_add_u32 s14, s14, s13
    buffer_load_dwordx4 v[68:71], v18, s[52:55], s14 offen nt
    s_add_u32 s14, s14, s13
    buffer_load_dwordx4 v[72:75], v18, s[52:55], s14 offen nt
    s_add_u32 s14, s14, s13
    buffer_load_dwordx4 v[76:79], v18, s[52:55], s14 offen nt
    s_add_u32 s14, s14, s13
    buffer_load_dwordx4 v[80:83], v18, s[52:55], s14 offen nt
    s_add_u32 s14, s14, s13
    buffer_load_dwordx4 v[84:87], v18, s[52:55], s14 offen nt
    s_add_u32 s14, s14, s13
    buffer_load_dwordx4 v[88:91], v18, s[52:55], s14 offen nt
    s_add_u32 s14, s14, s13
    buffer_load_dwordx4 v[92:95], v18, s[52:55], s14 offen nt
    s_add_u32 s14, s14, s13
    buffer_load_dwordx4 v[96:99], v18, s[52:55], s14 offen nt
    s_add_u32 s14, s14, s13
    buffer_load_dwordx4 v[100:103], v18, s[52:55], s14 offen nt
    s_add_u32 s14, s14, s13
    buffer_load_dwordx4 v[104:107], v18, s[52:55], s14 offen nt
    s_add_u32 s14, s14, s13
    buffer_load_dwordx4 v[108:111], v18, s[52:55], s14 offen nt
    s_cmp_eq_u32 s3, 0
    s_cbranch_scc0 L_q1
    s_barrier
L_q1:
    s_and_b32 s10, s5, 1
    s_lshr_b32 s11, s5, 1
    s_lshl_b32 s12, s4, 3
    s_add_u32 s12, s12, s5
    s_mov_b32 s48, 0xffff0000
    s_mov_b32 s49, 0x3db504f3
    s_mov_b32 s50, 0x3fb8aa3b
    v_lshlrev_b32 v20, 4, v1
    v_and_b32 v10, 1, v3
    v_lshl_add_u32 v21, v2, 1, v10
    s_cmp_eq_u32 s3, 0
    s_cbranch_scc0 L_fx
    s_lshl_b32 s6, s12, 10
    s_add_u32 s6, s6, 4096
    v_add_u32 v19, s6, v20
    s_branch L_ln
L_fx:
    v_lshl_add_u32 v19, v3, 7, v14
    s_lshl_b32 s6, s12, 9
    s_add_u32 s6, s6, 266240
    v_add_u32 v19, s6, v19
L_ln:
    v_bfe_u32 v9, v2, 1, 2
    v_and_b32 v10, 1, v2
    v_lshlrev_b32 v10, 4, v10
    v_mov_b32 v11, 0xffff
    v_lshlrev_b32 v10, v10, v11
    v_cmp_eq_u32 s[64:65], 0, v9
    v_cmp_eq_u32 s[66:67], 1, v9
    v_cmp_eq_u32 s[68:69], 2, v9
    v_cmp_eq_u32 s[70:71], 3, v9
    v_mov_b32 v8, 0xffffff00
    v_cndmask_b32 v4, 0, v10, s[64:65]
    v_cndmask_b32 v5, 0, v10, s[66:67]
    v_cndmask_b32 v6, 0, v10, s[68:69]
    v_cndmask_b32 v7, 0, v10, s[70:71]
    s_waitcnt vmcnt(18)
    v_lshlrev_b32 v32, 16, v24
    v_and_b32 v24, s48, v24
    v_lshlrev_b32 v33, 16, v25
    v_and_b32 v25, s48, v25
    v_lshlrev_b32 v34, 16, v26
    v_and_b32 v26, s48, v26
    v_lshlrev_b32 v35, 16, v27
    v_and_b32 v27, s48, v27
    v_lshlrev_b32 v36, 16, v28
    v_and_b32 v28, s48, v28
    v_lshlrev_b32 v37, 16, v29
    v_and_b32 v29, s48, v29
    v_lshlrev_b32 v38, 16, v30
    v_and_b32 v30, s48, v30
    v_lshlrev_b32 v39, 16, v31
    v_and_b32 v31, s48, v31
    v_add_f32 v9, v32, v24
    v_add_f32 v10, v33, v25
    v_add_f32 v9, v9, v34
    v_add_f32 v10, v10, v35
    v_add_f32 v9, v9, v26
    v_add_f32 v10, v10, v27
    v_add_f32 v9, v9, v36
    v_add_f32 v10, v10, v37
    v_add_f32 v9, v9, v28
    v_add_f32 v10, v10, v29
    v_add_f32 v9, v9, v38
    v_add_f32 v10, v10, v39
    v_add_f32 v9, v9, v30
    v_add_f32 v10, v10, v31
    v_add_f32 v9, v9, v10
    s_nop 1
    v_add_f32_dpp v9, v9, v9 quad_perm:[1,0,3,2] row_mask:0xf bank_mask:0xf
    s_nop 1
    v_add_f32_dpp v9, v9, v9 quad_perm:[2,3,0,1] row_mask:0xf bank_mask:0xf
    s_nop 1
    v_add_f32_dpp v9, v9, v9 row_half_mirror row_mask:0xf bank_mask:0xf
    v_mov_b32 v10, v9
    s_nop 1
    v_permlane16_swap_b32 v9, v10
    v_add_f32 v9, v9, v10
    v_mov_b32 v10, v9
    s_nop 1
    v_permlane32_swap_b32 v9, v10
    v_add_f32 v9, v9, v10
    v_mul_f32 v9, 0x3b000000, v9
    v_sub_f32 v32, v32, v9
    v_sub_f32 v24, v24, v9
    v_sub_f32 v33, v33, v9
    v_sub_f32 v25, v25, v9
    v_sub_f32 v34, v34, v9
    v_sub_f32 v26, v26, v9
    v_sub_f32 v35, v35, v9
    v_sub_f32 v27, v27, v9
    v_sub_f32 v36, v36, v9
    v_sub_f32 v28, v28, v9
    v_sub_f32 v37, v37, v9
    v_sub_f32 v29, v29, v9
    v_sub_f32 v38, v38, v9
    v_sub_f32 v30, v30, v9
    v_sub_f32 v39, v39, v9
    v_sub_f32 v31, v31, v9
    v_mul_f32 v10, v32, v32
    v_mul_f32 v11, v24, v24
    v_fmac_f32 v10, v33, v33
    v_fmac_f32 v11, v25, v25
    v_fmac_f32 v10, v34, v34
    v_fmac_f32 v11, v26, v26
    v_fmac_f32 v10, v35, v35
    v_fmac_f32 v11, v27, v27
    v_fmac_f32 v10, v36, v36
    v_fmac_f32 v11, v28, v28
    v_fmac_f32 v10, v37, v37
    v_fmac_f32 v11, v29, v29
    v_fmac_f32 v10, v38, v38
    v_fmac_f32 v11, v30, v30
    v_fmac_f32 v10, v39, v39
    v_fmac_f32 v11, v31, v31
    v_add_f32 v10, v10, v11
    s_nop 1
    v_add_f32_dpp v10, v10, v10 quad_perm:[1,0,3,2] row_mask:0xf bank_mask:0xf
    s_nop 1
    v_add_f32_dpp v10, v10, v10 quad_perm:[2,3,0,1] row_mask:0xf bank_mask:0xf
    s_nop 1
    v_add_f32_dpp v10, v10, v10 row_half_mirror row_mask:0xf bank_mask:0xf
    v_mov_b32 v11, v10
    s_nop 1
    v_permlane16_swap_b32 v10, v11
    v_add_f32 v10, v10, v11
    v_mov_b32 v11, v10
    s_nop 1
    v_permlane32_swap_b32 v10, v11
    v_add_f32 v10, v10, v11
    v_mul_f32 v10, 0x3b000000, v10
    v_cvt_pk_bf16_f32 v11, v9, v10
    v_lshlrev_b32 v9, 16, v11
    v_and_b32 v10, s48, v11
    v_add_f32 v10, 0x3727c5ac, v10
    v_cvt_pk_bf16_f32 v10, v10, v10
    v_and_b32 v10, s48, v10
    v_sqrt_f32 v10, v10
    s_nop 0
    v_cvt_pk_bf16_f32 v10, v10, v10
    v_and_b32 v10, s48, v10
    v_rcp_f32 v10, v10
    s_waitcnt vmcnt(16)
    v_lshlrev_b32 v32, 16, v40
    v_and_b32 v24, s48, v40
    v_sub_f32 v32, v32, v9
    v_sub_f32 v24, v24, v9
    v_cvt_pk_bf16_f32 v11, v32, v24
    v_lshlrev_b32 v32, 16, v11
    v_and_b32 v24, s48, v11
    v_mul_f32 v32, v32, v10
    v_mul_f32 v24, v24, v10
    v_lshlrev_b32 v33, 16, v41
    v_and_b32 v25, s48, v41
    v_sub_f32 v33, v33, v9
    v_sub_f32 v25, v25, v9
    v_cvt_pk_bf16_f32 v11, v33, v25
    v_lshlrev_b32 v33, 16, v11
    v_and_b32 v25, s48, v11
    v_mul_f32 v33, v33, v10
    v_mul_f32 v25, v25, v10
    v_lshlrev_b32 v34, 16, v42
    v_and_b32 v26, s48, v42
    v_sub_f32 v34, v34, v9
    v_sub_f32 v26, v26, v9
    v_cvt_pk_bf16_f32 v11, v34, v26
    v_lshlrev_b32 v34, 16, v11
    v_and_b32 v26, s48, v11
    v_mul_f32 v34, v34, v10
    v_mul_f32 v26, v26, v10
    v_lshlrev_b32 v35, 16, v43
    v_and_b32 v27, s48, v43
    v_sub_f32 v35, v35, v9
    v_sub_f32 v27, v27, v9
    v_cvt_pk_bf16_f32 v11, v35, v27
    v_lshlrev_b32 v35, 16, v11
    v_and_b32 v27, s48, v11
    v_mul_f32 v35, v35, v10
    v_mul_f32 v27, v27, v10
    v_lshlrev_b32 v36, 16, v44
    v_and_b32 v28, s48, v44
    v_sub_f32 v36, v36, v9
    v_sub_f32 v28, v28, v9
    v_cvt_pk_bf16_f32 v11, v36, v28
    v_lshlrev_b32 v36, 16, v11
    v_and_b32 v28, s48, v11
    v_mul_f32 v36, v36, v10
    v_mul_f32 v28, v28, v10
    v_lshlrev_b32 v37, 16, v45
    v_and_b32 v29, s48, v45
    v_sub_f32 v37, v37, v9
    v_sub_f32 v29, v29, v9
    v_cvt_pk_bf16_f32 v11, v37, v29
    v_lshlrev_b32 v37, 16, v11
    v_and_b32 v29, s48, v11
    v_mul_f32 v37, v37, v10
    v_mul_f32 v29, v29, v10
    v_lshlrev_b32 v38, 16, v46
    v_and_b32 v30, s48, v46
    v_sub_f32 v38, v38, v9
    v_sub_f32 v30, v30, v9
    v_cvt_pk_bf16_f32 v11, v38, v30
    v_lshlrev_b32 v38, 16, v11
    v_and_b32 v30, s48, v11
    v_mul_f32 v38, v38, v10
    v_mul_f32 v30, v30, v10
    v_lshlrev_b32 v39, 16, v47
    v_and_b32 v31, s48, v47
    v_sub_f32 v39, v39, v9
    v_sub_f32 v31, v31, v9
    v_cvt_pk_bf16_f32 v11, v39, v31
    v_lshlrev_b32 v39, 16, v11
    v_and_b32 v31, s48, v11
    v_mul_f32 v39, v39, v10
    v_mul_f32 v31, v31, v10
    v_cvt_pk_bf16_f32 v115, v32, v32
    v_and_b32 v112, v4, v115
    v_and_b32 v113, v5, v115
    v_and_b32 v114, v6, v115
    v_and_b32 v115, v7, v115
    v_cvt_pk_bf16_f32 v119, v24, v24
    v_and_b32 v116, v4, v119
    v_and_b32 v117, v5, v119
    v_and_b32 v118, v6, v119
    v_and_b32 v119, v7, v119
    s_waitcnt vmcnt(12)
    v_mfma_f32_16x16x32_bf16 v[120:123], v[112:115], v[48:51], 0
    v_cvt_pk_bf16_f32 v115, v33, v33
    v_and_b32 v112, v4, v115
    v_and_b32 v113, v5, v115
    v_and_b32 v114, v6, v115
    v_and_b32 v115, v7, v115
    v_mfma_f32_16x16x32_bf16 v[120:123], v[116:119], v[52:55], v[120:123]
    v_cvt_pk_bf16_f32 v119, v25, v25
    v_and_b32 v116, v4, v119
    v_and_b32 v117, v5, v119
    v_and_b32 v118, v6, v119
    v_and_b32 v119, v7, v119
    v_mfma_f32_16x16x32_bf16 v[120:123], v[112:115], v[56:59], v[120:123]
    v_cvt_pk_bf16_f32 v115, v34, v34
    v_and_b32 v112, v4, v115
    v_and_b32 v113, v5, v115
    v_and_b32 v114, v6, v115
    v_and_b32 v115, v7, v115
    v_mfma_f32_16x16x32_bf16 v[120:123], v[116:119], v[60:63], v[120:123]
    v_cvt_pk_bf16_f32 v119, v26, v26
    v_and_b32 v116, v4, v119
    v_and_b32 v117, v5, v119
    v_and_b32 v118, v6, v119
    v_and_b32 v119, v7, v119
    s_waitcnt vmcnt(8)
    v_mfma_f32_16x16x32_bf16 v[120:123], v[112:115], v[64:67], v[120:123]
    v_cvt_pk_bf16_f32 v115, v35, v35
    v_and_b32 v112, v4, v115
    v_and_b32 v113, v5, v115
    v_and_b32 v114, v6, v115
    v_and_b32 v115, v7, v115
    v_mfma_f32_16x16x32_bf16 v[120:123], v[116:119], v[68:71], v[120:123]
    v_cvt_pk_bf16_f32 v119, v27, v27
    v_and_b32 v116, v4, v119
    v_and_b32 v117, v5, v119
    v_and_b32 v118, v6, v119
    v_and_b32 v119, v7, v119
    v_mfma_f32_16x16x32_bf16 v[120:123], v[112:115], v[72:75], v[120:123]
    v_cvt_pk_bf16_f32 v115, v36, v36
    v_and_b32 v112, v4, v115
    v_and_b32 v113, v5, v115
    v_and_b32 v114, v6, v115
    v_and_b32 v115, v7, v115
    v_mfma_f32_16x16x32_bf16 v[120:123], v[116:119], v[76:79], v[120:123]
    v_cvt_pk_bf16_f32 v119, v28, v28
    v_and_b32 v116, v4, v119
    v_and_b32 v117, v5, v119
    v_and_b32 v118, v6, v119
    v_and_b32 v119, v7, v119
    s_waitcnt vmcnt(4)
    v_mfma_f32_16x16x32_bf16 v[120:123], v[112:115], v[80:83], v[120:123]
    v_cvt_pk_bf16_f32 v115, v37, v37
    v_and_b32 v112, v4, v115
    v_and_b32 v113, v5, v115
    v_and_b32 v114, v6, v115
    v_and_b32 v115, v7, v115
    v_mfma_f32_16x16x32_bf16 v[120:123], v[116:119], v[84:87], v[120:123]
    v_cvt_pk_bf16_f32 v119, v29, v29
    v_and_b32 v116, v4, v119
    v_and_b32 v117, v5, v119
    v_and_b32 v118, v6, v119
    v_and_b32 v119, v7, v119
    v_mfma_f32_16x16x32_bf16 v[120:123], v[112:115], v[88:91], v[120:123]
    v_cvt_pk_bf16_f32 v115, v38, v38
    v_and_b32 v112, v4, v115
    v_and_b32 v113, v5, v115
    v_and_b32 v114, v6, v115
    v_and_b32 v115, v7, v115
    v_mfma_f32_16x16x32_bf16 v[120:123], v[116:119], v[92:95], v[120:123]
    v_cvt_pk_bf16_f32 v119, v30, v30
    v_and_b32 v116, v4, v119
    v_and_b32 v117, v5, v119
    v_and_b32 v118, v6, v119
    v_and_b32 v119, v7, v119
    s_waitcnt vmcnt(0)
    v_mfma_f32_16x16x32_bf16 v[120:123], v[112:115], v[96:99], v[120:123]
    v_cvt_pk_bf16_f32 v115, v39, v39
    v_and_b32 v112, v4, v115
    v_and_b32 v113, v5, v115
    v_and_b32 v114, v6, v115
    v_and_b32 v115, v7, v115
    v_mfma_f32_16x16x32_bf16 v[120:123], v[116:119], v[100:103], v[120:123]
    v_cvt_pk_bf16_f32 v119, v31, v31
    v_and_b32 v116, v4, v119
    v_and_b32 v117, v5, v119
    v_and_b32 v118, v6, v119
    v_and_b32 v119, v7, v119
    v_mfma_f32_16x16x32_bf16 v[120:123], v[112:115], v[104:107], v[120:123]
    s_nop 1
    v_mfma_f32_16x16x32_bf16 v[120:123], v[116:119], v[108:111], v[120:123]
    s_waitcnt lgkmcnt(0)
    s_mul_i32 s6, s8, 0x9e3779b1
    s_add_u32 s6, s6, 0x7f4a7c15
    s_add_u32 s44, s8, 1
    s_and_b32 s44, s44, 0xff
    s_bfe_u32 s45, s6, 0x80008
    s_bfe_u32 s46, s6, 0x80010
    s_bfe_u32 s47, s6, 0x80018
    s_and_b32 s26, s6, 0xffffff00
    s_or_b32 s26, s26, s44
    s_getreg_b32 s7, hwreg(HW_REG_XCC_ID, 0, 4)
    s_and_b32 s38, s26, -16
    s_or_b32 s38, s38, s7
    s_mov_b32 s39, s38
    s_lshl_b32 s27, s4, 7
    s_add_u32 s27, s27, 663552
    v_and_or_b32 v120, v120, v8, s44
    v_and_or_b32 v121, v121, v8, s45
    v_and_or_b32 v122, v122, v8, s46
    v_and_or_b32 v123, v123, v8, s47
    s_mov_b32 s9, 20000
    s_cmp_eq_u32 s3, 0
    s_cbranch_scc0 L_f2
    global_store_dwordx4 v19, v[120:123], s[40:41]
    s_lshl_b32 s6, s5, 2
    s_add_u32 s6, s6, s27
    v_mov_b32 v9, s6
    v_mov_b32 v10, s38
    s_mov_b64 exec, 1
    global_store_dword v9, v10, s[40:41] sc1
    s_mov_b64 exec, -1
    s_mul_i32 s42, s43, 48
    s_lshl_b32 s6, s10, 2
    s_add_u32 s42, s42, s6
    s_lshl_b32 s6, s42, 10
    s_lshl_b32 s7, s11, 8
    s_add_u32 s6, s6, s7
    v_lshl_add_u32 v16, v3, 13, v14
    v_add_u32 v16, s6, v16
    v_and_b32 v10, 1, v3
    v_cmp_eq_u32 s[64:65], 1, v10
    v_lshrrev_b32 v9, 1, v3
    v_lshlrev_b32 v12, 1, v10
    v_lshl_add_u32 v12, v9, 3, v12
    s_add_u32 s6, s6, 32768
    v_lshl_add_u32 v17, v12, 10, v14
    v_add_u32 v17, s6, v17
    s_mov_b32 s56, s32
    s_mov_b32 s57, s33
    s_mov_b32 s58, 1409024
    s_mov_b32 s59, 0x20000
    s_mov_b32 s60, s30
    s_mov_b32 s61, s31
    s_mov_b32 s62, 2752
    s_mov_b32 s63, 0x20000
    buffer_load_dwordx4 v[140:143], v16, s[56:59], 0 offen offset:0 nt
    buffer_load_dwordx4 v[144:147], v16, s[56:59], 0 offen offset:1024 nt
    buffer_load_dwordx4 v[148:151], v16, s[56:59], 0 offen offset:2048 nt
    buffer_load_dwordx4 v[152:155], v16, s[56:59], 0 offen offset:3072 nt
    buffer_load_dwordx4 v[156:159], v17, s[56:59], 0 offen offset:0 nt
    buffer_load_dwordx4 v[160:163], v17, s[56:59], 0 offen offset:1024 nt
    s_lshl_b32 s6, s42, 1
    v_lshl_add_u32 v11, v3, 4, s6
    v_lshl_add_u32 v12, v12, 1, s6
    buffer_load_dwordx2 v[138:139], v11, s[60:63], 0 offen
    buffer_load_dword v137, v12, s[60:63], 0 offen offset:64
    s_lshl_b32 s13, s4, 1
    s_add_u32 s13, s13, s10
    s_and_b32 s14, s13, 15
    v_lshlrev_b32 v10, 2, v10
    v_and_or_b32 v10, v3, 2, v10
    v_and_b32 v11, 3, v1
    v_lshl_add_u32 v10, v11, 4, v10
    s_lshr_b32 s6, s13, 4
    s_lshl_b32 s6, s6, 8
    s_and_b32 s7, s14, 3
    s_lshl_b32 s7, s7, 6
    s_add_u32 s6, s6, s7
    s_and_b32 s7, s14, 4
    s_lshl_b32 s7, s7, 1
    s_add_u32 s6, s6, s7
    v_add_u32 v125, s6, v10
    s_and_b32 s7, s14, 8
    s_lshl_b32 s7, s7, 7
    v_add_u32 v124, s7, v125
    global_load_ushort v126, v124, s[16:17]
    global_load_ushort v127, v125, s[34:35]
    s_lshr_b32 s6, s13, 4
    s_lshl_b32 s6, s6, 16
    s_lshl_b32 s7, s14, 6
    s_add_u32 s6, s6, s7
    s_add_u32 s6, s6, 667648
    v_lshl_add_u32 v164, v11, 4, s6
    v_lshrrev_b32 v11, 2, v1
    v_lshl_add_u32 v164, v11, 10, v164
    v_add_u32 v165, 16384, v164
    v_add_u32 v166, 32768, v164
    v_add_u32 v167, 49152, v164
    s_lshl_b32 s7, s12, 10
    s_add_u32 s7, s7, 397312
    v_lshl_add_u32 v22, v1, 7, s7
    s_mov_b64 exec, 0xff
    s_mov_b64 exec, -1
    v_mov_b32 v9, s44
    v_mov_b32 v10, s45
    v_mov_b32 v11, s46
    v_mov_b32 v12, s47
    v_cndmask_b32 v135, v9, v11, s[64:65]
    v_cndmask_b32 v136, v10, v12, s[64:65]
    s_lshl_b32 s6, s4, 13
    s_add_u32 s6, s6, 8192
    v_add_u32 v130, s6, v20
    v_lshrrev_b32 v10, 1, v3
    v_lshlrev_b32 v131, 3, v21
    v_lshl_add_u32 v131, v10, 8, v131
    s_lshl_b32 s6, s11, 16
    s_lshl_b32 s7, s13, 10
    s_add_u32 s6, s6, s7
    s_add_u32 s6, s6, 667648
    v_add_u32 v132, s6, v20
    v_and_b32 v9, 7, v2
    v_lshrrev_b32 v11, 2, v13
    v_lshl_add_u32 v11, v9, 9, v11
    s_lshl_b32 s6, s4, 12
    s_lshl_b32 s7, s10, 7
    s_add_u32 s6, s6, s7
    s_add_u32 s6, s6, 266240
    v_add_u32 v11, s6, v11
    v_lshl_add_u32 v133, v3, 4, v11
    v_lshl_add_u32 v134, v3, 3, v11
    v_mov_b32 v12, 0
    v_mov_b32 v11, 1
    s_movk_i32 s7, 400
L_gq:
    s_load_dwordx8 s[64:71], s[40:41], s27 glc
    s_sub_u32 s7, s7, 1
    s_waitcnt lgkmcnt(0)
    s_cbranch_scc1 L_gq_s
    s_xor_b64 s[64:65], s[64:65], s[38:39]
    s_xor_b64 s[66:67], s[66:67], s[38:39]
    s_xor_b64 s[68:69], s[68:69], s[38:39]
    s_xor_b64 s[70:71], s[70:71], s[38:39]
    s_or_b64 s[64:65], s[64:65], s[66:67]
    s_or_b64 s[68:69], s[68:69], s[70:71]
    s_or_b64 s[64:65], s[64:65], s[68:69]
    s_cselect_b32 s51, 0, 1
    s_or_b32 s64, s64, s65
    s_lshr_b32 s64, s64, 4
    s_cbranch_scc1 L_gq
    s_cmp_eq_u32 s51, 1
    s_cbranch_scc1 L_gq_f
L_gq_s:
    s_mov_b32 s51, 0
    global_store_dwordx4 v19, v[120:123], s[40:41] sc1
L_gq_f:
L_pq:
    global_load_dwordx4 v[48:51], v130, s[40:41] offset:-4096 sc1
    global_load_dwordx4 v[52:55], v130, s[40:41] offset:-3072 sc1
    global_load_dwordx4 v[56:59], v130, s[40:41] offset:-2048 sc1
    global_load_dwordx4 v[60:63], v130, s[40:41] offset:-1024 sc1
    global_load_dwordx4 v[64:67], v130, s[40:41] offset:0 sc1
    global_load_dwordx4 v[68:71], v130, s[40:41] offset:1024 sc1
    global_load_dwordx4 v[72:75], v130, s[40:41] offset:2048 sc1
    global_load_dwordx4 v[76:79], v130, s[40:41] offset:3072 sc1
    s_waitcnt vmcnt(7)
    v_xor_b32 v48, s44, v48
    v_xor_b32 v49, s45, v49
    v_xor_b32 v50, s46, v50
    v_xor_b32 v51, s47, v51
    v_or_b32 v9, v48, v49
    v_or3_b32 v9, v9, v50, v51
    s_waitcnt vmcnt(6)
    v_xor_b32 v52, s44, v52
    v_xor_b32 v53, s45, v53
    v_xor_b32 v54, s46, v54
    v_xor_b32 v55, s47, v55
    v_or3_b32 v9, v9, v52, v53
    v_or3_b32 v9, v9, v54, v55
    s_waitcnt vmcnt(5)
    v_xor_b32 v56, s44, v56
    v_xor_b32 v57, s45, v57
    v_xor_b32 v58, s46, v58
    v_xor_b32 v59, s47, v59
    v_or3_b32 v9, v9, v56, v57
    v_or3_b32 v9, v9, v58, v59
    s_waitcnt vmcnt(4)
    v_xor_b32 v60, s44, v60
    v_xor_b32 v61, s45, v61
    v_xor_b32 v62, s46, v62
    v_xor_b32 v63, s47, v63
    v_or3_b32 v9, v9, v60, v61
    v_or3_b32 v9, v9, v62, v63
    s_waitcnt vmcnt(3)
    v_xor_b32 v64, s44, v64
    v_xor_b32 v65, s45, v65
    v_xor_b32 v66, s46, v66
    v_xor_b32 v67, s47, v67
    v_or3_b32 v9, v9, v64, v65
    v_or3_b32 v9, v9, v66, v67
    s_waitcnt vmcnt(2)
    v_xor_b32 v68, s44, v68
    v_xor_b32 v69, s45, v69
    v_xor_b32 v70, s46, v70
    v_xor_b32 v71, s47, v71
    v_or3_b32 v9, v9, v68, v69
    v_or3_b32 v9, v9, v70, v71
    s_waitcnt vmcnt(1)
    v_xor_b32 v72, s44, v72
    v_xor_b32 v73, s45, v73
    v_xor_b32 v74, s46, v74
    v_xor_b32 v75, s47, v75
    v_or3_b32 v9, v9, v72, v73
    v_or3_b32 v9, v9, v74, v75
    s_waitcnt vmcnt(0)
    v_xor_b32 v76, s44, v76
    v_xor_b32 v77, s45, v77
    v_xor_b32 v78, s46, v78
    v_xor_b32 v79, s47, v79
    v_or3_b32 v9, v9, v76, v77
    v_or3_b32 v9, v9, v78, v79
    v_and_b32 v9, 0xff, v9
    v_cmp_ne_u32 vcc, 0, v9
    s_cbranch_vccz L_pq_ok
    s_sub_u32 s9, s9, 1
    s_cmp_lg_u32 s9, 0
    s_cbranch_scc1 L_pq
L_pq_ok:
    v_add_f32 v48, v48, v52
    v_add_f32 v49, v49, v53
    v_add_f32 v50, v50, v54
    v_add_f32 v51, v51, v55
    v_add_f32 v56, v56, v60
    v_add_f32 v57, v57, v61
    v_add_f32 v58, v58, v62
    v_add_f32 v59, v59, v63
    v_add_f32 v64, v64, v68
    v_add_f32 v65, v65, v69
    v_add_f32 v66, v66, v70
    v_add_f32 v67, v67, v71
    v_add_f32 v72, v72, v76
    v_add_f32 v73, v73, v77
    v_add_f32 v74, v74, v78
    v_add_f32 v75, v75, v79
    v_add_f32 v48, v48, v56
    v_add_f32 v49, v49, v57
    v_add_f32 v50, v50, v58
    v_add_f32 v51, v51, v59
    v_add_f32 v64, v64, v72
    v_add_f32 v65, v65, v73
    v_add_f32 v66, v66, v74
    v_add_f32 v67, v67, v75
    v_add_f32 v48, v48, v64
    v_add_f32 v49, v49, v65
    v_add_f32 v50, v50, v66
    v_add_f32 v51, v51, v67
    v_cvt_pk_bf16_f32 v48, v48, v49
    v_cvt_pk_bf16_f32 v49, v50, v51
    ds_write_b64 v131, v[48:49] offset:0
    s_waitcnt lgkmcnt(0)
    s_mov_b64 exec, 1
    ds_write_b32 v12, v11 offset:512
    s_mov_b64 exec, -1
    global_load_dwordx4 v[32:35], v133, s[40:41]
    global_load_dwordx2 v[36:37], v134, s[40:41] offset:64
    s_mov_b32 s9, 20000
    s_branch L_ph_c
L_ph:
    global_load_dwordx4 v[32:35], v133, s[40:41] sc1
    global_load_dwordx2 v[36:37], v134, s[40:41] offset:64 sc1
L_ph_c:
    s_waitcnt vmcnt(0)
    v_xor_b32 v32, s44, v32
    v_xor_b32 v33, s45, v33
    v_xor_b32 v34, s46, v34
    v_xor_b32 v35, s47, v35
    v_xor_b32 v36, v135, v36
    v_xor_b32 v37, v136, v37
    v_or_b32 v9, v36, v37
    v_or3_b32 v9, v9, v32, v33
    v_or3_b32 v9, v9, v34, v35
    v_and_b32 v9, 0xff, v9
    v_cmp_ne_u32 vcc, 0, v9
    s_cbranch_vccz L_ph_ok
    s_sub_u32 s9, s9, 1
    s_cmp_lg_u32 s9, 0
    s_cbranch_scc1 L_ph
L_ph_ok:
    v_add_f32_dpp v32, v32, v32 quad_perm:[1,0,3,2] row_mask:0xf bank_mask:0xf
    v_add_f32_dpp v33, v33, v33 quad_perm:[1,0,3,2] row_mask:0xf bank_mask:0xf
    v_add_f32_dpp v34, v34, v34 quad_perm:[1,0,3,2] row_mask:0xf bank_mask:0xf
    v_add_f32_dpp v35, v35, v35 quad_perm:[1,0,3,2] row_mask:0xf bank_mask:0xf
    v_add_f32_dpp v36, v36, v36 quad_perm:[1,0,3,2] row_mask:0xf bank_mask:0xf
    v_add_f32_dpp v37, v37, v37 quad_perm:[1,0,3,2] row_mask:0xf bank_mask:0xf
    v_add_f32_dpp v32, v32, v32 quad_perm:[2,3,0,1] row_mask:0xf bank_mask:0xf
    v_add_f32_dpp v33, v33, v33 quad_perm:[2,3,0,1] row_mask:0xf bank_mask:0xf
    v_add_f32_dpp v34, v34, v34 quad_perm:[2,3,0,1] row_mask:0xf bank_mask:0xf
    v_add_f32_dpp v35, v35, v35 quad_perm:[2,3,0,1] row_mask:0xf bank_mask:0xf
    v_add_f32_dpp v36, v36, v36 quad_perm:[2,3,0,1] row_mask:0xf bank_mask:0xf
    v_add_f32_dpp v37, v37, v37 quad_perm:[2,3,0,1] row_mask:0xf bank_mask:0xf
    v_add_f32_dpp v32, v32, v32 row_half_mirror row_mask:0xf bank_mask:0xf
    v_add_f32_dpp v33, v33, v33 row_half_mirror row_mask:0xf bank_mask:0xf
    v_add_f32_dpp v34, v34, v34 row_half_mirror row_mask:0xf bank_mask:0xf
    v_add_f32_dpp v35, v35, v35 row_half_mirror row_mask:0xf bank_mask:0xf
    v_add_f32_dpp v36, v36, v36 row_half_mirror row_mask:0xf bank_mask:0xf
    v_add_f32_dpp v37, v37, v37 row_half_mirror row_mask:0xf bank_mask:0xf
    v_cvt_pk_bf16_f32 v9, v32, v33
    v_lshlrev_b32 v32, 16, v9
    v_and_b32 v33, s48, v9
    v_cvt_pk_bf16_f32 v9, v34, v35
    v_lshlrev_b32 v34, 16, v9
    v_and_b32 v35, s48, v9
    v_cvt_pk_bf16_f32 v9, v36, v37
    v_lshlrev_b32 v36, 16, v9
    v_and_b32 v37, s48, v9
    v_lshlrev_b32 v9, 16, v138
    v_and_b32 v10, s48, v138
    v_add_f32 v32, v32, v9
    v_add_f32 v33, v33, v10
    v_lshlrev_b32 v9, 16, v139
    v_and_b32 v10, s48, v139
    v_add_f32 v34, v34, v9
    v_add_f32 v35, v35, v10
    v_lshlrev_b32 v9, 16, v137
    v_and_b32 v10, s48, v137
    v_add_f32 v36, v36, v9
    v_add_f32 v37, v37, v10
    v_cvt_pk_bf16_f32 v9, v32, v33
    v_lshlrev_b32 v32, 16, v9
    v_and_b32 v33, s48, v9
    v_cvt_pk_bf16_f32 v9, v34, v35
    v_lshlrev_b32 v34, 16, v9
    v_and_b32 v35, s48, v9
    v_cvt_pk_bf16_f32 v9, v36, v37
    v_lshlrev_b32 v36, 16, v9
    v_and_b32 v37, s48, v9
    v_max_f32 v32, 0, v32
    v_max_f32 v33, 0, v33
    v_max_f32 v34, 0, v34
    v_max_f32 v35, 0, v35
    v_max_f32 v36, 0, v36
    v_max_f32 v37, 0, v37
    v_mul_f32 v32, v32, v32
    v_mul_f32 v33, v33, v33
    v_mul_f32 v34, v34, v34
    v_mul_f32 v35, v35, v35
    v_mul_f32 v36, v36, v36
    v_mul_f32 v37, v37, v37
    v_cvt_pk_bf16_f32 v83, v32, v32
    v_and_b32 v80, v4, v83
    v_and_b32 v81, v5, v83
    v_and_b32 v82, v6, v83
    v_and_b32 v83, v7, v83
    v_cvt_pk_bf16_f32 v87, v33, v33
    v_and_b32 v84, v4, v87
    v_and_b32 v85, v5, v87
    v_and_b32 v86, v6, v87
    v_and_b32 v87, v7, v87
    v_cvt_pk_bf16_f32 v91, v34, v34
    v_and_b32 v88, v4, v91
    v_and_b32 v89, v5, v91
    v_and_b32 v90, v6, v91
    v_and_b32 v91, v7, v91
    v_cvt_pk_bf16_f32 v95, v35, v35
    v_and_b32 v92, v4, v95
    v_and_b32 v93, v5, v95
    v_and_b32 v94, v6, v95
    v_and_b32 v95, v7, v95
    v_cvt_pk_bf16_f32 v99, v36, v36
    v_and_b32 v96, v4, v99
    v_and_b32 v97, v5, v99
    v_and_b32 v98, v6, v99
    v_and_b32 v99, v7, v99
    v_cvt_pk_bf16_f32 v103, v37, v37
    v_and_b32 v100, v4, v103
    v_and_b32 v101, v5, v103
    v_and_b32 v102, v6, v103
    v_and_b32 v103, v7, v103
    s_nop 1
    v_mfma_f32_16x16x32_bf16 v[120:123], v[80:83], v[140:143], 0
    v_mfma_f32_16x16x32_bf16 v[120:123], v[84:87], v[144:147], v[120:123]
    v_mfma_f32_16x16x32_bf16 v[120:123], v[88:91], v[148:151], v[120:123]
    v_mfma_f32_16x16x32_bf16 v[120:123], v[92:95], v[152:155], v[120:123]
    v_mfma_f32_16x16x32_bf16 v[120:123], v[96:99], v[156:159], v[120:123]
    v_mfma_f32_16x16x32_bf16 v[120:123], v[100:103], v[160:163], v[120:123]
    s_nop 2
    v_and_b32 v22, 1, v1
    v_lshlrev_b32 v16, 6, v22
    v_lshrrev_b32 v9, 1, v1
    v_mul_u32_u24 v17, 2176, v22
    v_lshl_add_u32 v17, v9, 4, v17
    v_and_or_b32 v120, v120, v8, s44
    v_and_or_b32 v121, v121, v8, s45
    v_and_or_b32 v122, v122, v8, s46
    v_and_or_b32 v123, v123, v8, s47
    s_lshl_b32 s6, s12, 4
    s_add_u32 s6, s6, 659456
    v_lshl_add_u32 v18, v22, 3, s6
    s_lshl_b32 s6, s4, 13
    s_lshl_b32 s7, s5, 5
    s_add_u32 s6, s6, s7
    s_add_u32 s6, s6, 397312
    v_lshrrev_b32 v9, 1, v1
    v_lshl_add_u32 v19, v9, 8, s6
    v_and_b32 v9, 1, v1
    v_lshl_add_u32 v19, v9, 4, v19
    s_waitcnt lgkmcnt(0)
    v_cmp_eq_u32 s[64:65], 1, v22
    v_mov_b32 v9, s44
    v_mov_b32 v10, s45
    v_mov_b32 v11, s46
    v_mov_b32 v12, s47
    v_cndmask_b32 v135, v9, v11, s[64:65]
    v_cndmask_b32 v136, v10, v12, s[64:65]
    v_mov_b32 v22, 0
    v_lshlrev_b32 v127, 16, v127
    v_lshlrev_b32 v126, 16, v126
    s_mov_b32 s9, 320000
L_wm:
    ds_read_b128 v[48:51], v16 offset:640
    ds_read_b128 v[52:55], v16 offset:656
    ds_read_b128 v[56:59], v16 offset:672
    ds_read_b128 v[60:63], v16 offset:688
    s_waitcnt lgkmcnt(0)
    v_and_b32 v9, v50, v54
    v_and_b32 v10, v58, v62
    v_and_b32 v9, v9, v10
    v_cmp_ne_u32 vcc, 1, v9
    s_cbranch_vccz L_wm_ok
    s_sleep 1
    s_sub_u32 s9, s9, 1
    s_cmp_lg_u32 s9, 0
    s_cbranch_scc1 L_wm
L_wm_ok:
    v_max3_f32 v32, v48, v52, v56
    v_max_f32 v32, v32, v60
    v_sub_f32 v24, v48, v32
    v_sub_f32 v25, v52, v32
    v_sub_f32 v26, v56, v32
    v_sub_f32 v27, v60, v32
    v_mul_f32 v24, s50, v24
    v_mul_f32 v25, s50, v25
    v_mul_f32 v26, s50, v26
    v_mul_f32 v27, s50, v27
    v_exp_f32 v24, v24
    v_exp_f32 v25, v25
    v_exp_f32 v26, v26
    v_exp_f32 v27, v27
    v_mul_f32 v33, v24, v49
    v_fmac_f32 v33, v25, v53
    v_fmac_f32 v33, v26, v57
    v_fmac_f32 v33, v27, v61
    v_and_or_b32 v32, v32, v8, v135
    v_and_or_b32 v33, v33, v8, v136
    s_mov_b64 exec, 3
    s_cmp_eq_u32 s51, 0
    s_cbranch_scc1 L_ps0
    global_store_dwordx2 v18, v[32:33], s[40:41]
    s_branch L_pd0
L_ps0:
    global_store_dwordx2 v18, v[32:33], s[40:41] sc1
L_pd0:
    s_mov_b64 exec, -1
    s_mov_b32 s9, 20000
    s_barrier
    ds_read_b128 v[48:51], v17 offset:1024
    ds_read_b128 v[52:55], v17 offset:1568
    ds_read_b128 v[56:59], v17 offset:2112
    ds_read_b128 v[60:63], v17 offset:2656
    s_waitcnt lgkmcnt(3)
    v_mul_f32 v48, v48, v24
    v_mul_f32 v49, v49, v24
    v_mul_f32 v50, v50, v24
    v_mul_f32 v51, v51, v24
    s_waitcnt lgkmcnt(2)
    v_fmac_f32 v48, v52, v25
    v_fmac_f32 v49, v53, v25
    v_fmac_f32 v50, v54, v25
    v_fmac_f32 v51, v55, v25
    s_waitcnt lgkmcnt(1)
    v_fmac_f32 v48, v56, v26
    v_fmac_f32 v49, v57, v26
    v_fmac_f32 v50, v58, v26
    v_fmac_f32 v51, v59, v26
    s_waitcnt lgkmcnt(0)
    v_fmac_f32 v48, v60, v27
    v_fmac_f32 v49, v61, v27
    v_fmac_f32 v50, v62, v27
    v_fmac_f32 v51, v63, v27
    v_and_or_b32 v48, v48, v8, s44
    v_and_or_b32 v49, v49, v8, s45
    v_and_or_b32 v50, v50, v8, s46
    v_and_or_b32 v51, v51, v8, s47
    s_cmp_eq_u32 s51, 0
    s_cbranch_scc1 L_ps1
    global_store_dwordx4 v19, v[48:51], s[40:41]
    s_branch L_pd1
L_ps1:
    global_store_dwordx4 v19, v[48:51], s[40:41] sc1
L_pd1:
    global_store_dwordx4 v132, v[120:123], s[40:41] sc1
    s_barrier
    s_cmp_ge_u32 s5, 2
    s_cbranch_scc1 L_noep
    v_add_u32 v140, 262144, v164
    v_add_u32 v141, 262144, v165
    v_add_u32 v142, 262144, v166
    v_add_u32 v143, 262144, v167
    s_barrier
    s_barrier
L_pf:
    global_load_dwordx4 v[64:67], v164, s[40:41] sc1
    global_load_dwordx4 v[68:71], v165, s[40:41] sc1
    global_load_dwordx4 v[72:75], v166, s[40:41] sc1
    global_load_dwordx4 v[76:79], v167, s[40:41] sc1
    global_load_dwordx4 v[80:83], v140, s[40:41] sc1
    global_load_dwordx4 v[84:87], v141, s[40:41] sc1
    global_load_dwordx4 v[88:91], v142, s[40:41] sc1
    global_load_dwordx4 v[92:95], v143, s[40:41] sc1
    s_waitcnt vmcnt(7)
    v_xor_b32 v64, s44, v64
    v_xor_b32 v65, s45, v65
    v_xor_b32 v66, s46, v66
    v_xor_b32 v67, s47, v67
    v_or_b32 v9, v64, v65
    v_or3_b32 v9, v9, v66, v67
    s_waitcnt vmcnt(6)
    v_xor_b32 v68, s44, v68
    v_xor_b32 v69, s45, v69
    v_xor_b32 v70, s46, v70
    v_xor_b32 v71, s47, v71
    v_or3_b32 v9, v9, v68, v69
    v_or3_b32 v9, v9, v70, v71
    v_add_f32 v64, v64, v68
    v_add_f32 v65, v65, v69
    v_add_f32 v66, v66, v70
    v_add_f32 v67, v67, v71
    s_waitcnt vmcnt(5)
    v_xor_b32 v72, s44, v72
    v_xor_b32 v73, s45, v73
    v_xor_b32 v74, s46, v74
    v_xor_b32 v75, s47, v75
    v_or3_b32 v9, v9, v72, v73
    v_or3_b32 v9, v9, v74, v75
    v_add_f32 v64, v64, v72
    v_add_f32 v65, v65, v73
    v_add_f32 v66, v66, v74
    v_add_f32 v67, v67, v75
    s_waitcnt vmcnt(4)
    v_xor_b32 v76, s44, v76
    v_xor_b32 v77, s45, v77
    v_xor_b32 v78, s46, v78
    v_xor_b32 v79, s47, v79
    v_or3_b32 v9, v9, v76, v77
    v_or3_b32 v9, v9, v78, v79
    v_add_f32 v64, v64, v76
    v_add_f32 v65, v65, v77
    v_add_f32 v66, v66, v78
    v_add_f32 v67, v67, v79
    v_and_b32 v9, 0xff, v9
    v_cmp_ne_u32 vcc, 0, v9
    s_cbranch_vccz L_pf_ok
    s_sub_u32 s9, s9, 1
    s_cmp_lg_u32 s9, 0
    s_cbranch_scc1 L_pf
L_pf_ok:
    v_mov_b32 v164, v140
    v_mov_b32 v165, v141
    v_mov_b32 v166, v142
    v_mov_b32 v167, v143
    v_permlane32_swap_b32 v64, v65
    v_permlane32_swap_b32 v66, v67
    v_add_f32 v64, v64, v65
    v_add_f32 v66, v66, v67
    s_nop 1
    v_permlane16_swap_b32 v64, v66
    v_add_f32 v64, v64, v66
    s_nop 1
    v_add_f32_dpp v64, v64, v64 row_ror:8 row_mask:0xf bank_mask:0xf
    s_nop 1
    v_add_f32_dpp v64, v64, v64 row_ror:4 row_mask:0xf bank_mask:0xf
    v_cvt_pk_bf16_f32 v64, v64, v64
    v_and_b32 v64, s48, v64
    v_add_f32 v64, v64, v127
    v_cvt_pk_bf16_f32 v64, v64, v64
    v_and_b32 v64, s48, v64
    v_mul_f32 v9, s50, v64
    v_exp_f32 v9, -v9
    s_nop 0
    v_add_f32 v9, 1.0, v9
    v_rcp_f32 v9, v9
    s_nop 0
    v_mul_f32 v128, v64, v9
    v_cvt_pk_bf16_f32 v128, v128, v128
    v_and_b32 v128, s48, v128
    s_mov_b32 s9, 20000
L_pb:
    global_load_dwordx4 v[96:99], v164, s[40:41] sc1
    global_load_dwordx4 v[100:103], v165, s[40:41] sc1
    global_load_dwordx4 v[104:107], v166, s[40:41] sc1
    global_load_dwordx4 v[108:111], v167, s[40:41] sc1
    s_waitcnt vmcnt(7)
    v_xor_b32 v80, s44, v80
    v_xor_b32 v81, s45, v81
    v_xor_b32 v82, s46, v82
    v_xor_b32 v83, s47, v83
    v_or_b32 v9, v80, v81
    v_or3_b32 v9, v9, v82, v83
    s_waitcnt vmcnt(6)
    v_xor_b32 v84, s44, v84
    v_xor_b32 v85, s45, v85
    v_xor_b32 v86, s46, v86
    v_xor_b32 v87, s47, v87
    v_or3_b32 v9, v9, v84, v85
    v_or3_b32 v9, v9, v86, v87
    v_add_f32 v24, v80, v84
    v_add_f32 v25, v81, v85
    v_add_f32 v26, v82, v86
    v_add_f32 v27, v83, v87
    s_waitcnt vmcnt(5)
    v_xor_b32 v88, s44, v88
    v_xor_b32 v89, s45, v89
    v_xor_b32 v90, s46, v90
    v_xor_b32 v91, s47, v91
    v_or3_b32 v9, v9, v88, v89
    v_or3_b32 v9, v9, v90, v91
    v_add_f32 v24, v24, v88
    v_add_f32 v25, v25, v89
    v_add_f32 v26, v26, v90
    v_add_f32 v27, v27, v91
    s_waitcnt vmcnt(4)
    v_xor_b32 v92, s44, v92
    v_xor_b32 v93, s45, v93
    v_xor_b32 v94, s46, v94
    v_xor_b32 v95, s47, v95
    v_or3_b32 v9, v9, v92, v93
    v_or3_b32 v9, v9, v94, v95
    v_add_f32 v24, v24, v92
    v_add_f32 v25, v25, v93
    v_add_f32 v26, v26, v94
    v_add_f32 v27, v27, v95
    v_and_b32 v9, 0xff, v9
    v_cmp_ne_u32 vcc, 0, v9
    s_cbranch_vccz L_pb_ok
    global_load_dwordx4 v[80:83], v164, s[40:41] sc1
    global_load_dwordx4 v[84:87], v165, s[40:41] sc1
    global_load_dwordx4 v[88:91], v166, s[40:41] sc1
    global_load_dwordx4 v[92:95], v167, s[40:41] sc1
    s_waitcnt vmcnt(7)
    v_xor_b32 v96, s44, v96
    v_xor_b32 v97, s45, v97
    v_xor_b32 v98, s46, v98
    v_xor_b32 v99, s47, v99
    v_or_b32 v9, v96, v97
    v_or3_b32 v9, v9, v98, v99
    s_waitcnt vmcnt(6)
    v_xor_b32 v100, s44, v100
    v_xor_b32 v101, s45, v101
    v_xor_b32 v102, s46, v102
    v_xor_b32 v103, s47, v103
    v_or3_b32 v9, v9, v100, v101
    v_or3_b32 v9, v9, v102, v103
    v_add_f32 v24, v96, v100
    v_add_f32 v25, v97, v101
    v_add_f32 v26, v98, v102
    v_add_f32 v27, v99, v103
    s_waitcnt vmcnt(5)
    v_xor_b32 v104, s44, v104
    v_xor_b32 v105, s45, v105
    v_xor_b32 v106, s46, v106
    v_xor_b32 v107, s47, v107
    v_or3_b32 v9, v9, v104, v105
    v_or3_b32 v9, v9, v106, v107
    v_add_f32 v24, v24, v104
    v_add_f32 v25, v25, v105
    v_add_f32 v26, v26, v106
    v_add_f32 v27, v27, v107
    s_waitcnt vmcnt(4)
    v_xor_b32 v108, s44, v108
    v_xor_b32 v109, s45, v109
    v_xor_b32 v110, s46, v110
    v_xor_b32 v111, s47, v111
    v_or3_b32 v9, v9, v108, v109
    v_or3_b32 v9, v9, v110, v111
    v_add_f32 v24, v24, v108
    v_add_f32 v25, v25, v109
    v_add_f32 v26, v26, v110
    v_add_f32 v27, v27, v111
    v_and_b32 v9, 0xff, v9
    v_cmp_ne_u32 vcc, 0, v9
    s_cbranch_vccz L_pb_ok
    s_sub_u32 s9, s9, 1
    s_cmp_lg_u32 s9, 0
    s_cbranch_scc1 L_pb
L_pb_ok:
    v_permlane32_swap_b32 v24, v25
    v_permlane32_swap_b32 v26, v27
    v_add_f32 v24, v24, v25
    v_add_f32 v26, v26, v27
    s_nop 1
    v_permlane16_swap_b32 v24, v26
    v_add_f32 v24, v24, v26
    s_nop 1
    v_add_f32_dpp v24, v24, v24 row_ror:8 row_mask:0xf bank_mask:0xf
    s_nop 1
    v_add_f32_dpp v24, v24, v24 row_ror:4 row_mask:0xf bank_mask:0xf
    v_cvt_pk_bf16_f32 v24, v24, v24
    v_and_b32 v24, s48, v24
    v_mul_f32 v24, v24, v128
    v_cvt_pk_bf16_f32 v24, v24, v24
    v_and_b32 v24, s48, v24
    v_add_f32 v24, v24, v126
    v_cvt_pk_bf16_f32 v24, v24, v24
    s_mov_b32 exec_lo, 0x000f000f
    s_mov_b32 exec_hi, 0x000f000f
    global_store_short v124, v24, s[36:37]
    s_cmp_lg_u32 s2, 0
    s_cbranch_scc1 L_noep
    s_add_u32 s6, s8, 1
    v_mov_b32 v9, s6
    s_mov_b64 exec, 1
    global_store_dword v22, v9, s[40:41]
L_noep:
    s_endpgm
L_f2:
    s_mov_b32 exec_lo, 0x00ff00ff
    s_mov_b32 exec_hi, 0x00ff00ff
    global_store_dwordx4 v19, v[120:123], s[40:41]
    s_movk_i32 s7, 400
L_gh:
    s_load_dwordx8 s[64:71], s[40:41], s27 glc
    s_sub_u32 s7, s7, 1
    s_waitcnt lgkmcnt(0)
    s_cbranch_scc1 L_gh_s
    s_xor_b64 s[64:65], s[64:65], s[38:39]
    s_xor_b64 s[66:67], s[66:67], s[38:39]
    s_xor_b64 s[68:69], s[68:69], s[38:39]
    s_xor_b64 s[70:71], s[70:71], s[38:39]
    s_or_b64 s[64:65], s[64:65], s[66:67]
    s_or_b64 s[68:69], s[68:69], s[70:71]
    s_or_b64 s[64:65], s[64:65], s[68:69]
    s_cselect_b32 s51, 0, 1
    s_or_b32 s64, s64, s65
    s_lshr_b32 s64, s64, 4
    s_cbranch_scc1 L_gh
    s_cmp_eq_u32 s51, 1
    s_cbranch_scc1 L_gh_f
L_gh_s:
    s_mov_b32 s51, 0
    global_store_dwordx4 v19, v[120:123], s[40:41] sc1
L_gh_f:
    s_endpgm
L_stream:
    s_sub_u32 s13, s3, 2
    s_lshr_b32 s14, s13, 2
    s_and_b32 s6, s13, 3
    s_lshl_b32 s6, s6, 13
    s_lshl_b32 s15, s14, 25
    s_lshl_b32 s7, s4, 20
    s_add_u32 s15, s15, s7
    s_add_u32 s15, s15, s6
    s_lshl_b32 s7, s5, 15
    s_add_u32 s15, s15, s7
    s_add_u32 s15, s15, 786432
    s_lshl_b32 s6, s2, 3
    s_add_u32 s6, s6, s13
    s_mul_i32 s6, s6, 0x9e3779b1
    s_lshr_b32 s6, s6, 29
    s_lshl_b32 s43, s6, 10
    v_lshlrev_b32 v9, 2, v3
    v_xor_b32 v9, v2, v9
    v_lshl_add_u32 v10, v3, 8, s15
    v_lshl_add_u32 v16, v9, 4, v10
    v_xor_b32 v11, 1, v9
    v_lshl_add_u32 v17, v11, 4, v10
    v_xor_b32 v11, 2, v9
    v_lshl_add_u32 v18, v11, 4, v10
    v_xor_b32 v11, 3, v9
    v_lshl_add_u32 v19, v11, 4, v10
    s_lshl_b32 s61, s13, 13
    s_add_u32 s61, s61, 16384
    v_add_u32 v24, v10, v14
    s_mov_b32 s54, 67108864
    s_mov_b32 s55, 0x20000
    s_mov_b32 s58, 67108864
    s_mov_b32 s59, 0x20000
    s_waitcnt lgkmcnt(0)
    s_mov_b32 s52, s18
    s_mov_b32 s53, s19
    s_mov_b32 s56, s20
    s_mov_b32 s57, s21
    s_load_dword s8, s[40:41], 0
    s_xor_b32 m0, s61, 0
    s_xor_b32 s62, s43, 0
    buffer_load_dwordx4 v16, s[52:55], s62 offen nt lds
    s_barrier
    s_xor_b32 m0, s61, 1024
    s_xor_b32 s62, s43, 1024
    buffer_load_dwordx4 v17, s[52:55], s62 offen nt lds
    s_and_b32 s10, s5, 1
    s_lshr_b32 s11, s5, 1
    s_lshl_b32 s12, s4, 3
    s_add_u32 s12, s12, s5
    s_mov_b32 s48, 0xffff0000
    s_mov_b32 s49, 0x3db504f3
    s_mov_b32 s50, 0x3fb8aa3b
    v_and_b32 v1, 63, v0
    v_and_b32 v13, 8, v0
    v_lshlrev_b32 v13, 7, v13
    v_bfe_u32 v9, v2, 1, 2
    v_and_b32 v10, 1, v2
    v_lshlrev_b32 v10, 4, v10
    v_mov_b32 v11, 0xffff
    v_lshlrev_b32 v10, v10, v11
    v_cmp_eq_u32 s[64:65], 0, v9
    v_cmp_eq_u32 s[66:67], 1, v9
    v_cmp_eq_u32 s[68:69], 2, v9
    v_cmp_eq_u32 s[70:71], 3, v9
    v_mov_b32 v8, 0xffffff00
    v_cndmask_b32 v4, 0, v10, s[64:65]
    v_cndmask_b32 v5, 0, v10, s[66:67]
    v_cndmask_b32 v6, 0, v10, s[68:69]
    v_cndmask_b32 v7, 0, v10, s[70:71]
    s_waitcnt lgkmcnt(0)
    s_mul_i32 s6, s8, 0x9e3779b1
    s_add_u32 s6, s6, 0x7f4a7c15
    s_add_u32 s44, s8, 1
    s_and_b32 s44, s44, 0xff
    s_bfe_u32 s45, s6, 0x80008
    s_bfe_u32 s46, s6, 0x80010
    s_bfe_u32 s47, s6, 0x80018
    s_and_b32 s26, s6, 0xffffff00
    s_or_b32 s26, s26, s44
    s_getreg_b32 s7, hwreg(HW_REG_XCC_ID, 0, 4)
    s_and_b32 s38, s26, -16
    s_or_b32 s38, s38, s7
    s_mov_b32 s39, s38
    s_lshl_b32 s27, s4, 7
    s_add_u32 s27, s27, 663552
    s_lshl_b32 s6, s4, 7
    s_lshl_b32 s7, s10, 6
    s_add_u32 s6, s6, s7
    s_lshr_b32 s7, s13, 1
    s_lshl_b32 s7, s7, 4
    s_add_u32 s6, s6, s7
    s_and_b32 s7, s13, 1
    s_lshl_b32 s7, s7, 1
    s_add_u32 s6, s6, s7
    s_lshl_b32 s6, s6, 10
    s_lshl_b32 s7, s11, 8
    s_add_u32 s6, s6, s7
    v_lshl_add_u32 v25, v3, 12, v14
    v_add_u32 v25, s6, v25
    s_lshl_b32 s6, s14, 8
    v_lshl_add_u32 v26, v3, 4, s6
    v_mov_b32 v38, 0
    s_lshl_b32 s6, s13, 13
    s_add_u32 s6, s6, 16384
    v_and_b32 v9, 3, v2
    v_lshl_add_u32 v10, v9, 10, s6
    v_lshrrev_b32 v9, 2, v2
    v_lshl_add_u32 v10, v9, 8, v10
    v_xor_b32 v9, v2, v3
    v_lshl_add_u32 v20, v9, 4, v10
    v_xor_b32 v11, 4, v9
    v_lshl_add_u32 v21, v11, 4, v10
    v_xor_b32 v11, 8, v9
    v_lshl_add_u32 v22, v11, 4, v10
    v_xor_b32 v11, 12, v9
    v_lshl_add_u32 v23, v11, 4, v10
    s_mul_i32 s6, s13, 544
    v_lshl_add_u32 v27, v2, 5, s6
    v_lshl_add_u32 v27, v3, 4, v27
    s_lshl_b32 s6, s13, 4
    v_mov_b32 v30, s6
    v_and_b32 v9, 7, v0
    s_lshl_b32 s6, s4, 13
    s_lshl_b32 s7, s10, 12
    s_add_u32 s6, s6, s7
    s_lshr_b32 s7, s13, 1
    s_lshl_b32 s7, s7, 10
    s_add_u32 s6, s6, s7
    s_add_u32 s6, s6, 397312
    v_lshl_add_u32 v28, v9, 5, s6
    v_lshrrev_b32 v10, 4, v1
    v_lshl_add_u32 v28, v10, 8, v28
    v_bfe_u32 v10, v1, 3, 1
    v_lshl_add_u32 v28, v10, 4, v28
    v_lshrrev_b32 v10, 7, v13
    v_lshl_add_u32 v29, v9, 4, v10
    s_lshl_b32 s6, s4, 7
    s_add_u32 s6, s6, 659456
    v_add_u32 v29, s6, v29
    s_mul_i32 s6, s13, 1024
    v_lshl_add_u32 v31, v1, 4, s6
    v_lshl_add_u32 v10, v3, 3, v9
    s_lshl_b32 s6, s13, 9
    v_lshl_add_u32 v10, v10, 4, s6
    v_lshl_add_u32 v32, v13, 2, v10
    s_lshl_b32 s6, s11, 16
    s_lshl_b32 s7, s4, 11
    s_add_u32 s6, s6, s7
    s_lshl_b32 s7, s10, 10
    s_add_u32 s6, s6, s7
    s_add_u32 s6, s6, 929792
    v_add_u32 v33, s6, v10
    v_cmp_ne_u32 s[66:67], 0, v13
    s_bitcmp1_b32 s13, 0
    s_cselect_b64 s[68:69], -1, 0
    v_mov_b32 v9, s44
    v_mov_b32 v10, s45
    v_mov_b32 v11, s46
    v_mov_b32 v12, s47
    v_cndmask_b32 v36, v9, v11, s[66:67]
    v_cndmask_b32 v37, v10, v12, s[66:67]
    v_mov_b32 v42, 1
    v_mov_b32 v43, 1
    s_xor_b32 m0, s61, 2048
    s_xor_b32 s62, s43, 2048
    s_waitcnt vmcnt(1)
    buffer_load_dwordx4 v18, s[52:55], s62 offen nt lds
    s_xor_b32 m0, s61, 3072
    s_xor_b32 s62, s43, 3072
    s_waitcnt vmcnt(1)
    buffer_load_dwordx4 v19, s[52:55], s62 offen nt lds
    s_xor_b32 m0, s61, 4096
    s_xor_b32 s62, s43, 4096
    s_waitcnt vmcnt(1)
    buffer_load_dwordx4 v16, s[52:55], s62 offen nt lds
    s_xor_b32 m0, s61, 5120
    s_xor_b32 s62, s43, 5120
    s_waitcnt vmcnt(2)
    buffer_load_dwordx4 v17, s[52:55], s62 offen nt lds
    s_xor_b32 m0, s61, 6144
    s_xor_b32 s62, s43, 6144
    s_waitcnt vmcnt(2)
    buffer_load_dwordx4 v18, s[52:55], s62 offen nt lds
    s_xor_b32 m0, s61, 7168
    s_xor_b32 s62, s43, 7168
    s_waitcnt vmcnt(2)
    buffer_load_dwordx4 v19, s[52:55], s62 offen nt lds
    s_waitcnt vmcnt(2)
    s_xor_b32 s62, s43, 0
    buffer_load_dwordx4 v[108:111], v24, s[56:59], s62 offen nt
    s_waitcnt vmcnt(2)
    s_xor_b32 s62, s43, 1024
    buffer_load_dwordx4 v[112:115], v24, s[56:59], s62 offen nt
    ds_read_b32 v39, v38 offset:512
    s_waitcnt lgkmcnt(0)
    v_cmp_ne_u32 vcc, 1, v39
    s_cbranch_vccz L_c9
    s_waitcnt vmcnt(2)
    s_xor_b32 s62, s43, 2048
    buffer_load_dwordx4 v[116:119], v24, s[56:59], s62 offen nt
    ds_read_b32 v39, v38 offset:512
    s_waitcnt lgkmcnt(0)
    v_cmp_ne_u32 vcc, 1, v39
    s_cbranch_vccz L_c10
    s_waitcnt vmcnt(2)
    s_xor_b32 s62, s43, 3072
    buffer_load_dwordx4 v[120:123], v24, s[56:59], s62 offen nt
    ds_read_b32 v39, v38 offset:512
    s_waitcnt lgkmcnt(0)
    v_cmp_ne_u32 vcc, 1, v39
    s_cbranch_vccz L_c11
    s_waitcnt vmcnt(2)
    s_xor_b32 s62, s43, 4096
    buffer_load_dwordx4 v[124:127], v24, s[56:59], s62 offen nt
    ds_read_b32 v39, v38 offset:512
    s_waitcnt lgkmcnt(0)
    v_cmp_ne_u32 vcc, 1, v39
    s_cbranch_vccz L_c12
    s_waitcnt vmcnt(2)
    s_xor_b32 s62, s43, 5120
    buffer_load_dwordx4 v[128:131], v24, s[56:59], s62 offen nt
    ds_read_b32 v39, v38 offset:512
    s_waitcnt lgkmcnt(0)
    v_cmp_ne_u32 vcc, 1, v39
    s_cbranch_vccz L_c13
    s_waitcnt vmcnt(2)
    s_xor_b32 s62, s43, 6144
    buffer_load_dwordx4 v[132:135], v24, s[56:59], s62 offen nt
    ds_read_b32 v39, v38 offset:512
    s_waitcnt lgkmcnt(0)
    v_cmp_ne_u32 vcc, 1, v39
    s_cbranch_vccz L_c14
    s_waitcnt vmcnt(2)
    s_xor_b32 s62, s43, 7168
    buffer_load_dwordx4 v[136:139], v24, s[56:59], s62 offen nt
    s_mov_b32 s63, 16
    s_waitcnt vmcnt(8)
    s_branch L_qk
L_c9:
    s_xor_b32 s62, s43, 2048
    buffer_load_dwordx4 v[116:119], v24, s[56:59], s62 offen nt
    s_xor_b32 s62, s43, 3072
    buffer_load_dwordx4 v[120:123], v24, s[56:59], s62 offen nt
    s_mov_b32 s63, 12
    s_waitcnt vmcnt(4)
    s_branch L_qk
L_c10:
    s_xor_b32 s62, s43, 3072
    buffer_load_dwordx4 v[120:123], v24, s[56:59], s62 offen nt
    s_xor_b32 s62, s43, 4096
    buffer_load_dwordx4 v[124:127], v24, s[56:59], s62 offen nt
    s_mov_b32 s63, 13
    s_waitcnt vmcnt(5)
    s_branch L_qk
L_c11:
    s_xor_b32 s62, s43, 4096
    buffer_load_dwordx4 v[124:127], v24, s[56:59], s62 offen nt
    s_xor_b32 s62, s43, 5120
    buffer_load_dwordx4 v[128:131], v24, s[56:59], s62 offen nt
    s_mov_b32 s63, 14
    s_waitcnt vmcnt(6)
    s_branch L_qk
L_c12:
    s_xor_b32 s62, s43, 5120
    buffer_load_dwordx4 v[128:131], v24, s[56:59], s62 offen nt
    s_xor_b32 s62, s43, 6144
    buffer_load_dwordx4 v[132:135], v24, s[56:59], s62 offen nt
    s_mov_b32 s63, 15
    s_waitcnt vmcnt(7)
    s_branch L_qk
L_c13:
    s_xor_b32 s62, s43, 6144
    buffer_load_dwordx4 v[132:135], v24, s[56:59], s62 offen nt
    s_xor_b32 s62, s43, 7168
    buffer_load_dwordx4 v[136:139], v24, s[56:59], s62 offen nt
    s_mov_b32 s63, 16
    s_waitcnt vmcnt(8)
    s_branch L_qk
L_c14:
    s_xor_b32 s62, s43, 7168
    buffer_load_dwordx4 v[136:139], v24, s[56:59], s62 offen nt
    s_mov_b32 s63, 16
    s_waitcnt vmcnt(8)
L_qk:
    ds_read_b128 v[76:79], v20 offset:0
    ds_read_b128 v[80:83], v21 offset:0
    ds_read_b128 v[84:87], v22 offset:0
    ds_read_b128 v[88:91], v23 offset:0
    ds_read_b128 v[92:95], v20 offset:4096
    ds_read_b128 v[96:99], v21 offset:4096
    ds_read_b128 v[100:103], v22 offset:4096
    ds_read_b128 v[104:107], v23 offset:4096
    s_mov_b32 s9, 320000
L_wq:
    ds_read_b32 v39, v38 offset:512
    ds_read_b128 v[60:63], v26 offset:0
    ds_read_b128 v[64:67], v26 offset:64
    ds_read_b128 v[68:71], v26 offset:128
    ds_read_b128 v[72:75], v26 offset:192
    s_waitcnt lgkmcnt(0)
    v_cmp_ne_u32 vcc, 1, v39
    s_cbranch_vccz L_wq_ok
    s_sleep 2
    s_sub_u32 s9, s9, 1
    s_cmp_lg_u32 s9, 0
    s_cbranch_scc1 L_wq
L_wq_ok:
    v_mfma_f32_16x16x32_bf16 v[148:151], v[76:79], v[60:63], 0
    v_mfma_f32_16x16x32_bf16 v[152:155], v[92:95], v[60:63], 0
    v_mfma_f32_16x16x32_bf16 v[148:151], v[80:83], v[64:67], v[148:151]
    v_mfma_f32_16x16x32_bf16 v[152:155], v[96:99], v[64:67], v[152:155]
    v_mfma_f32_16x16x32_bf16 v[148:151], v[84:87], v[68:71], v[148:151]
    v_mfma_f32_16x16x32_bf16 v[152:155], v[100:103], v[68:71], v[152:155]
    v_mfma_f32_16x16x32_bf16 v[148:151], v[88:91], v[72:75], v[148:151]
    v_mfma_f32_16x16x32_bf16 v[152:155], v[104:107], v[72:75], v[152:155]
    s_nop 7
    v_cvt_pk_bf16_f32 v9, v148, v149
    v_lshlrev_b32 v148, 16, v9
    v_and_b32 v149, s48, v9
    v_cvt_pk_bf16_f32 v9, v150, v151
    v_lshlrev_b32 v150, 16, v9
    v_and_b32 v151, s48, v9
    v_cvt_pk_bf16_f32 v9, v152, v153
    v_lshlrev_b32 v152, 16, v9
    v_and_b32 v153, s48, v9
    v_cvt_pk_bf16_f32 v9, v154, v155
    v_lshlrev_b32 v154, 16, v9
    v_and_b32 v155, s48, v9
    v_mul_f32 v148, s49, v148
    v_mul_f32 v149, s49, v149
    v_mul_f32 v150, s49, v150
    v_mul_f32 v151, s49, v151
    v_mul_f32 v152, s49, v152
    v_mul_f32 v153, s49, v153
    v_mul_f32 v154, s49, v154
    v_mul_f32 v155, s49, v155
    v_cvt_pk_bf16_f32 v9, v148, v149
    v_lshlrev_b32 v148, 16, v9
    v_and_b32 v149, s48, v9
    v_cvt_pk_bf16_f32 v9, v150, v151
    v_lshlrev_b32 v150, 16, v9
    v_and_b32 v151, s48, v9
    v_cvt_pk_bf16_f32 v9, v152, v153
    v_lshlrev_b32 v152, 16, v9
    v_and_b32 v153, s48, v9
    v_cvt_pk_bf16_f32 v9, v154, v155
    v_lshlrev_b32 v154, 16, v9
    v_and_b32 v155, s48, v9
    v_max3_f32 v40, v148, v149, v150
    v_max3_f32 v40, v40, v151, v152
    v_max3_f32 v40, v40, v153, v154
    v_max_f32 v40, v40, v155
    v_mov_b32 v9, v40
    s_nop 1
    v_permlane16_swap_b32 v40, v9
    v_max_f32 v40, v40, v9
    v_mov_b32 v9, v40
    s_nop 1
    v_permlane32_swap_b32 v40, v9
    v_max_f32 v40, v40, v9
    v_sub_f32 v148, v148, v40
    v_sub_f32 v149, v149, v40
    v_sub_f32 v150, v150, v40
    v_sub_f32 v151, v151, v40
    v_sub_f32 v152, v152, v40
    v_sub_f32 v153, v153, v40
    v_sub_f32 v154, v154, v40
    v_sub_f32 v155, v155, v40
    v_mul_f32 v148, s50, v148
    v_mul_f32 v149, s50, v149
    v_mul_f32 v150, s50, v150
    v_mul_f32 v151, s50, v151
    v_mul_f32 v152, s50, v152
    v_mul_f32 v153, s50, v153
    v_mul_f32 v154, s50, v154
    v_mul_f32 v155, s50, v155
    v_exp_f32 v148, v148
    v_exp_f32 v149, v149
    v_exp_f32 v150, v150
    v_exp_f32 v151, v151
    v_exp_f32 v152, v152
    v_exp_f32 v153, v153
    v_exp_f32 v154, v154
    v_exp_f32 v155, v155
    v_add_f32 v41, v148, v149
    v_add_f32 v41, v41, v150
    v_add_f32 v41, v41, v151
    v_add_f32 v41, v41, v152
    v_add_f32 v41, v41, v153
    v_add_f32 v41, v41, v154
    v_add_f32 v41, v41, v155
    v_mov_b32 v9, v41
    s_nop 1
    v_permlane16_swap_b32 v41, v9
    v_add_f32 v41, v41, v9
    v_mov_b32 v9, v41
    s_nop 1
    v_permlane32_swap_b32 v41, v9
    v_add_f32 v41, v41, v9
    s_mov_b64 exec, 1
    ds_write_b128 v30, v[40:43] offset:640
    s_mov_b64 exec, -1
    s_cmp_eq_u32 s63, 16
    s_cbranch_scc1 L_u16
    s_cmp_eq_u32 s63, 15
    s_cbranch_scc1 L_u15
    s_cmp_eq_u32 s63, 14
    s_cbranch_scc1 L_u14
    s_cmp_eq_u32 s63, 13
    s_cbranch_scc1 L_u13
    s_xor_b32 s62, s43, 4096
    buffer_load_dwordx4 v[124:127], v24, s[56:59], s62 offen nt
L_u13:
    s_xor_b32 s62, s43, 5120
    buffer_load_dwordx4 v[128:131], v24, s[56:59], s62 offen nt
L_u14:
    s_xor_b32 s62, s43, 6144
    buffer_load_dwordx4 v[132:135], v24, s[56:59], s62 offen nt
L_u15:
    s_xor_b32 s62, s43, 7168
    buffer_load_dwordx4 v[136:139], v24, s[56:59], s62 offen nt
L_u16:
    v_cvt_pk_bf16_f32 v79, v148, v148
    v_and_b32 v76, v4, v79
    v_and_b32 v77, v5, v79
    v_and_b32 v78, v6, v79
    v_and_b32 v79, v7, v79
    v_cvt_pk_bf16_f32 v83, v149, v149
    v_and_b32 v80, v4, v83
    v_and_b32 v81, v5, v83
    v_and_b32 v82, v6, v83
    v_and_b32 v83, v7, v83
    v_cvt_pk_bf16_f32 v87, v150, v150
    v_and_b32 v84, v4, v87
    v_and_b32 v85, v5, v87
    v_and_b32 v86, v6, v87
    v_and_b32 v87, v7, v87
    v_cvt_pk_bf16_f32 v91, v151, v151
    v_and_b32 v88, v4, v91
    v_and_b32 v89, v5, v91
    v_and_b32 v90, v6, v91
    v_and_b32 v91, v7, v91
    v_cvt_pk_bf16_f32 v95, v152, v152
    v_and_b32 v92, v4, v95
    v_and_b32 v93, v5, v95
    v_and_b32 v94, v6, v95
    v_and_b32 v95, v7, v95
    v_cvt_pk_bf16_f32 v99, v153, v153
    v_and_b32 v96, v4, v99
    v_and_b32 v97, v5, v99
    v_and_b32 v98, v6, v99
    v_and_b32 v99, v7, v99
    v_cvt_pk_bf16_f32 v103, v154, v154
    v_and_b32 v100, v4, v103
    v_and_b32 v101, v5, v103
    v_and_b32 v102, v6, v103
    v_and_b32 v103, v7, v103
    v_cvt_pk_bf16_f32 v107, v155, v155
    v_and_b32 v104, v4, v107
    v_and_b32 v105, v5, v107
    v_and_b32 v106, v6, v107
    v_and_b32 v107, v7, v107
    s_mov_b32 s9, 20000
    s_waitcnt vmcnt(7)
    v_mfma_f32_16x16x32_bf16 v[148:151], v[76:79], v[108:111], 0
    s_waitcnt vmcnt(6)
    v_mfma_f32_16x16x32_bf16 v[148:151], v[80:83], v[112:115], v[148:151]
    s_waitcnt vmcnt(5)
    v_mfma_f32_16x16x32_bf16 v[148:151], v[84:87], v[116:119], v[148:151]
    s_waitcnt vmcnt(4)
    v_mfma_f32_16x16x32_bf16 v[148:151], v[88:91], v[120:123], v[148:151]
    s_waitcnt vmcnt(3)
    v_mfma_f32_16x16x32_bf16 v[148:151], v[92:95], v[124:127], v[148:151]
    s_waitcnt vmcnt(2)
    v_mfma_f32_16x16x32_bf16 v[148:151], v[96:99], v[128:131], v[148:151]
    s_waitcnt vmcnt(1)
    v_mfma_f32_16x16x32_bf16 v[148:151], v[100:103], v[132:135], v[148:151]
    s_waitcnt vmcnt(0)
    v_mfma_f32_16x16x32_bf16 v[148:151], v[104:107], v[136:139], v[148:151]
    s_nop 0
    s_nop 5
    s_mov_b32 exec_hi, 0
    ds_write_b128 v27, v[148:151] offset:1024
    s_mov_b32 exec_hi, -1
    s_waitcnt lgkmcnt(0)
    s_barrier
    global_load_dwordx2 v[44:45], v29, s[40:41] sc1
    s_barrier
    global_load_dwordx4 v[140:143], v25, s[24:25] nt
    global_load_dwordx4 v[144:147], v25, s[24:25] offset:1024 nt
    s_waitcnt vmcnt(2)
    s_branch L_pml_c
L_pml:
    global_load_dwordx2 v[44:45], v29, s[40:41] sc1
    s_waitcnt vmcnt(0)
L_pml_c:
    v_xor_b32 v44, v44, v36
    v_xor_b32 v45, v45, v37
    v_or_b32 v9, v44, v45
    v_and_b32 v9, 0xff, v9
    v_cmp_ne_u32 vcc, 0, v9
    s_cbranch_vccz L_pml_ok
    s_sleep 1
    s_sub_u32 s9, s9, 1
    s_cmp_lg_u32 s9, 0
    s_cbranch_scc1 L_pml
L_pml_ok:
    v_mov_b32 v9, v44
    s_nop 1
    v_max_f32_dpp v9, v9, v9 quad_perm:[1,0,3,2] row_mask:0xf bank_mask:0xf
    s_nop 1
    v_max_f32_dpp v9, v9, v9 quad_perm:[2,3,0,1] row_mask:0xf bank_mask:0xf
    s_nop 1
    v_max_f32_dpp v9, v9, v9 row_half_mirror row_mask:0xf bank_mask:0xf
    v_sub_f32 v9, v44, v9
    v_mul_f32 v9, s50, v9
    v_exp_f32 v9, v9
    s_nop 0
    v_mul_f32 v10, v9, v45
    s_nop 1
    v_add_f32_dpp v10, v10, v10 quad_perm:[1,0,3,2] row_mask:0xf bank_mask:0xf
    s_nop 1
    v_add_f32_dpp v10, v10, v10 quad_perm:[2,3,0,1] row_mask:0xf bank_mask:0xf
    s_nop 1
    v_add_f32_dpp v10, v10, v10 row_half_mirror row_mask:0xf bank_mask:0xf
    v_rcp_f32 v10, v10
    s_mov_b32 s9, 20000
    v_mul_f32 v12, v9, v10
    global_load_dwordx4 v[48:51], v28, s[40:41] sc1
    s_branch L_pa2
L_pa:
    global_load_dwordx4 v[48:51], v28, s[40:41] sc1
L_pa2:
    s_waitcnt vmcnt(0)
    v_xor_b32 v48, s44, v48
    v_xor_b32 v49, s45, v49
    v_xor_b32 v50, s46, v50
    v_xor_b32 v51, s47, v51
    v_or_b32 v9, v48, v49
    v_or3_b32 v9, v9, v50, v51
    v_and_b32 v9, 0xff, v9
    v_cmp_ne_u32 vcc, 0, v9
    s_cbranch_vccz L_pa_ok
    s_sleep 1
    s_sub_u32 s9, s9, 1
    s_cmp_lg_u32 s9, 0
    s_cbranch_scc1 L_pa
L_pa_ok:
    v_cndmask_b32 v48, v48, v50, s[68:69]
    v_cndmask_b32 v49, v49, v51, s[68:69]
    v_mul_f32 v48, v48, v12
    v_mul_f32 v49, v49, v12
    s_nop 0
    v_add_f32_dpp v48, v48, v48 quad_perm:[1,0,3,2] row_mask:0xf bank_mask:0xf
    v_add_f32_dpp v49, v49, v49 quad_perm:[1,0,3,2] row_mask:0xf bank_mask:0xf
    s_nop 0
    v_add_f32_dpp v48, v48, v48 quad_perm:[2,3,0,1] row_mask:0xf bank_mask:0xf
    v_add_f32_dpp v49, v49, v49 quad_perm:[2,3,0,1] row_mask:0xf bank_mask:0xf
    s_nop 0
    v_add_f32_dpp v48, v48, v48 row_half_mirror row_mask:0xf bank_mask:0xf
    v_add_f32_dpp v49, v49, v49 row_half_mirror row_mask:0xf bank_mask:0xf
    v_cvt_pk_bf16_f32 v63, v48, v48
    v_and_b32 v60, v4, v63
    v_and_b32 v61, v5, v63
    v_and_b32 v62, v6, v63
    v_and_b32 v63, v7, v63
    v_cvt_pk_bf16_f32 v67, v49, v49
    v_and_b32 v64, v4, v67
    v_and_b32 v65, v5, v67
    v_and_b32 v66, v6, v67
    v_and_b32 v67, v7, v67
    s_nop 0
    v_mfma_f32_16x16x32_bf16 v[148:151], v[60:63], v[140:143], 0
    v_mfma_f32_16x16x32_bf16 v[148:151], v[64:67], v[144:147], v[148:151]
    s_nop 7
    ds_write_b128 v31, v[148:151] offset:5632
    s_waitcnt lgkmcnt(0)
    s_barrier
    s_cmp_ge_u32 s13, 2
    s_cbranch_scc1 L_sdone
    ds_read_b128 v[108:111], v32 offset:5632
    ds_read_b128 v[112:115], v32 offset:6656
    ds_read_b128 v[116:119], v32 offset:7680
    ds_read_b128 v[120:123], v32 offset:8704
    s_waitcnt lgkmcnt(2)
    v_add_f32 v108, v108, v112
    v_add_f32 v109, v109, v113
    v_add_f32 v110, v110, v114
    v_add_f32 v111, v111, v115
    s_waitcnt lgkmcnt(0)
    v_add_f32 v116, v116, v120
    v_add_f32 v117, v117, v121
    v_add_f32 v118, v118, v122
    v_add_f32 v119, v119, v123
    v_add_f32 v108, v108, v116
    v_add_f32 v109, v109, v117
    v_add_f32 v110, v110, v118
    v_add_f32 v111, v111, v119
    v_add_f32_dpp v108, v108, v108 row_ror:8 row_mask:0xf bank_mask:0xf
    v_add_f32_dpp v109, v109, v109 row_ror:8 row_mask:0xf bank_mask:0xf
    v_add_f32_dpp v110, v110, v110 row_ror:8 row_mask:0xf bank_mask:0xf
    v_add_f32_dpp v111, v111, v111 row_ror:8 row_mask:0xf bank_mask:0xf
    v_and_or_b32 v108, v108, v8, s44
    v_and_or_b32 v109, v109, v8, s45
    v_and_or_b32 v110, v110, v8, s46
    v_and_or_b32 v111, v111, v8, s47
    s_mov_b32 exec_lo, 0x00ff00ff
    s_mov_b32 exec_hi, 0x00ff00ff
    global_store_dwordx4 v33, v[108:111], s[40:41] sc1
L_sdone:
    s_barrier
L_end:
    s_endpgm
.section .rodata,"a"
.p2align 6
.amdhsa_kernel recurrent_scan__sliding_block_cached__dense_activation_squared_relu__decode_kernel
  .amdhsa_next_free_vgpr 168
  .amdhsa_next_free_sgpr 102
  .amdhsa_accum_offset 168
  .amdhsa_group_segment_fixed_size 0
  .amdhsa_kernarg_size 104
  .amdhsa_user_sgpr_count 2
  .amdhsa_user_sgpr_kernarg_segment_ptr 1
  .amdhsa_system_sgpr_workgroup_id_x 1
.end_amdhsa_kernel
```
